```python
import torch

def _softmax(x, axis=-1):
    return torch.softmax(x, dim=axis)
def _gelu(x):
    return torch.nn.functional.gelu(x, approximate="tanh")
def _silu(x):
    return torch.nn.functional.silu(x)
def _sigmoid(x):
    return torch.sigmoid(x)
def _layernorm(x, axis=-1, eps=1e-5):
    m = x.mean(dim=axis, keepdim=True)
    v = x.var(dim=axis, keepdim=True, unbiased=False)
    return (x - m) / torch.sqrt(v + eps)
def _scatter_add(tgt, idx, src, axis=0):
    return tgt.clone().index_add_(axis, idx, src)
def _segment_sum(src, seg, n):
    out = torch.zeros((n,) + src.shape[1:], dtype=src.dtype)
    return out.index_add_(0, seg, src)
def _pad(x, pw):
    flat = tuple(v for pair in reversed(pw) for v in pair)
    return torch.nn.functional.pad(x, flat)

kernel_name = 'sequential_preLN__sliding_block_cached__glu_gated_reglu__decode'

def setup_inputs():

    _w = (lambda a: (lambda t: t.to(torch.bfloat16) if t.is_floating_point() else t)(torch.as_tensor(a)))
    def _A_setup():
        B, Sq, D = 1, 1, 512
        Hq, Hkv, Sk, Dh = 32, 8, 32768, 128
        assert Hq % Hkv == 0, (Hq, Hkv)
        return {
            "x": _w((lambda *s: torch.randn(*s, dtype=torch.bfloat16) * 0.05)(B, Sq, D)),
            "k_cache": _w((lambda *s: torch.randn(*s, dtype=torch.bfloat16) * 1.6)(B, Hkv, Sk, Dh)),
            "v_cache": _w((lambda *s: torch.randn(*s, dtype=torch.bfloat16) * 0.8)(B, Hkv, Sk, Dh)),
            "wq": _w((lambda *s: torch.randn(*s, dtype=torch.bfloat16) * 1.6)(D, Hq * Dh) * (D ** -0.5)),
            "wo": _w((lambda *s: torch.randn(*s, dtype=torch.bfloat16) * 0.8)(Hq * Dh, D) * ((Hq * Dh) ** -0.5)),
        }
    _A_in = _A_setup()

    def _B_setup():
        B, S, D, F = 1, 1, 512, 1792
        return {
            "x": _w((lambda *s: torch.randn(*s, dtype=torch.bfloat16) * 0.05)(B, S, D)),
            "W_gate": _w((lambda *s: torch.randn(*s, dtype=torch.bfloat16) * 0.4)(D, F) * (2.0 / D) ** 0.5),
            "W_up": _w((lambda *s: torch.randn(*s, dtype=torch.bfloat16) * 0.4)(D, F) * (2.0 / D) ** 0.5),
            "W_down": _w((lambda *s: torch.randn(*s, dtype=torch.bfloat16) * 0.4)(F, D) * (1.0 / F) ** 0.5),
        }
    _B_in = _B_setup()

    return {
        "A_x": _A_in["x"],
        "A_k_cache": _A_in["k_cache"],
        "A_v_cache": _A_in["v_cache"],
        "A_wq": _A_in["wq"],
        "A_wo": _A_in["wo"],
        "B_x": _B_in["x"],
        "B_W_gate": _B_in["W_gate"],
        "B_W_up": _B_in["W_up"],
        "B_W_down": _B_in["W_down"],
    }

def reference(A_x, A_k_cache, A_v_cache, A_wq, A_wo, B_x, B_W_gate, B_W_up, B_W_down):
    def _A_ref(x, k_cache, v_cache, wq, wo):
        B, Sq, D = x.shape
        Hq, Dh = 32, 128
        Hkv, Sk = k_cache.shape[1], k_cache.shape[2]
        W = min(4096, max(256, Sk // 4))
        rep = Hq // Hkv
        q = (lambda x, *d: x.permute(*d))((x @ wq).reshape(B, Sq, Hq, Dh), 0, 2, 1, 3)
        k = (lambda x, n, axis: torch.repeat_interleave(x, n, dim=axis))(k_cache[:, :, Sk - W:, :], rep, axis=1)
        v = (lambda x, n, axis: torch.repeat_interleave(x, n, dim=axis))(v_cache[:, :, Sk - W:, :], rep, axis=1)
        scores = torch.einsum("bhqd,bhkd->bhqk", q, k) * (Dh ** -0.5)
        p = _softmax(scores, axis=-1)
        o = torch.einsum("bhqk,bhkd->bhqd", p, v)
        return (lambda x, *d: x.permute(*d))(o, 0, 2, 1, 3).reshape(B, Sq, Hq * Dh) @ wo

    def _B_ref(x, W_gate, W_up, W_down):
        gate = torch.einsum("bsd,df->bsf", x, W_gate)
        up = torch.einsum("bsd,df->bsf", x, W_up)
        gate = gate * (lambda x, dt: x.to(dt))(gate > 0, gate.dtype)
        h = gate * up
        return torch.einsum("bsf,fd->bsd", h, W_down)

    x = A_x
    h = x + _A_ref(_layernorm(x, axis=-1), A_k_cache, A_v_cache, A_wq, A_wo)
    h2 = h + _B_ref(_layernorm(h, axis=-1), B_W_gate, B_W_up, B_W_down)
    return h2
```

```asm
; @launch grid=(256,1,1) block=(512,1,1) lds=106496
.amdgcn_target "amdgcn-amd-amdhsa--gfx950"
.text
.globl sequential_preLN__sliding_block_cached__glu_gated_reglu__decode_kernel
.p2align 12
.type sequential_preLN__sliding_block_cached__glu_gated_reglu__decode_kernel,@function
sequential_preLN__sliding_block_cached__glu_gated_reglu__decode_kernel:
    s_load_dwordx2 s[40:41], s[0:1], 24
    s_load_dwordx2 s[36:37], s[0:1], 0
    s_load_dwordx2 s[16:17], s[0:1], 88
    s_load_dwordx2 s[44:45], s[0:1], 8
    s_lshr_b32 s5, s2, 3
    s_cmp_ge_u32 s5, 32
    s_cbranch_scc1 L_END0
    v_readfirstlane_b32 s3, v0
    v_and_b32 v1, 63, v0
    s_and_b32 s4, s2, 7
    s_and_b32 s32, s5, 3
    s_lshr_b32 s59, s5, 2
    v_lshrrev_b32 v8, 3, v0
    v_and_b32 v7, 7, v0
    v_lshlrev_b32 v25, 4, v7
    v_lshl_or_b32 v22, v8, 14, v25
    s_lshl_b32 s24, s32, 20
    s_lshl_b32 s26, s4, 10
    s_add_u32 s24, s24, s26
    s_lshl_b32 s26, s59, 7
    s_add_u32 s24, s24, s26
    s_movk_i32 s100, 8192
    s_add_u32 s25, s24, s100
    s_mov_b32 s39, 0x20000
    s_lshl_b32 s42, s39, 5
    s_mov_b32 s43, s39
    s_movk_i32 s38, 1024
    v_lshlrev_b32 v20, 4, v1
    v_lshlrev_b32 v21, 2, v8
    s_lshl_b32 s27, s32, 8
    s_waitcnt lgkmcnt(0)
    buffer_load_dwordx4 v[44:47], v20, s[36:39], 0 offen
    buffer_load_dword v132, v21, s[36:39], s27 offen
    buffer_load_dwordx4 v[48:51], v22, s[40:43], s24 offen nt
    buffer_load_dwordx4 v[52:55], v22, s[40:43], s25 offen nt
    s_load_dwordx2 s[6:7], s[16:17], 0
    s_lshr_b32 s3, s3, 6
    s_lshl_b32 s18, s39, 6
    s_mov_b32 s19, s39
    s_add_u32 s28, s4, 8
    s_lshl_b32 s28, s28, 12
    v_lshlrev_b32 v9, 3, v0
    buffer_load_dword v139, v9, s[16:19], s28 offen sc1
    v_lshrrev_b32 v3, 6, v0
    v_and_b32 v5, 15, v1
    v_lshrrev_b32 v6, 4, v1
    s_lshl_b32 s99, s4, 8
    s_add_u32 s99, s99, s5
    s_addk_i32 s99, 224
    s_lshl_b32 s99, s99, 15
    v_xor_b32 v9, v5, v6
    v_lshlrev_b32 v9, 4, v9
    v_lshl_or_b32 v10, v3, 12, v9
    v_lshl_or_b32 v23, v6, 8, v10
    v_lshl_or_b32 v124, v5, 8, v10
    s_lshl_b32 s46, s39, 9
    s_mov_b32 s47, s39
    s_add_u32 s97, s3, 10
    s_lshl_b32 m0, s97, 12
    s_barrier
    buffer_load_dwordx4 v23, s[44:47], s99 offen offset:0 nt lds
    v_xor_b32 v19, 0x40, v23
    buffer_load_dwordx4 v19, s[44:47], s99 offen offset:1024 nt lds
    v_xor_b32 v19, 0x80, v23
    buffer_load_dwordx4 v19, s[44:47], s99 offen offset:2048 nt lds
    s_load_dwordx2 s[48:49], s[0:1], 16
    s_load_dwordx2 s[56:57], s[0:1], 32
    s_load_dwordx4 s[60:63], s[0:1], 48
    s_load_dwordx2 s[52:53], s[0:1], 64
    s_mov_b32 s12, 0x05040100
    s_mov_b32 s13, 0x07060302
    s_mov_b32 s15, 0x3f803f80
    s_mov_b32 s58, 0xffff0000
    s_mov_b32 s101, 0x3fb8aa3b
    s_mov_b64 s[50:51], s[46:47]
    v_lshrrev_b32 v4, 5, v1
    v_mov_b32 v2, 0
    s_getreg_b32 s34, hwreg(HW_REG_XCC_ID, 0, 4)
    v_lshlrev_b32 v13, 1, v25
    v_lshl_or_b32 v13, v6, 3, v13
    v_lshl_or_b32 v13, v3, 8, v13
    v_and_b32 v15, 31, v1
    v_lshlrev_b32 v14, 3, v15
    v_lshl_or_b32 v14, v4, 10, v14
    v_lshrrev_b32 v10, 4, v0
    v_and_b32 v11, 2, v3
    v_lshl_or_b32 v11, v11, 1, v6
    v_lshlrev_b32 v11, 1, v11
    v_xor_b32 v11, v11, v5
    v_lshlrev_b32 v128, 4, v11
    v_lshl_or_b32 v138, v10, 8, v128
    s_add_u32 s98, s3, 8
    s_lshl_b32 s98, s98, 10
    s_add_u32 s33, s98, 0x10000
    s_add_u32 s10, s16, s28
    s_addc_u32 s11, s17, 0
    s_lshl2_add_u32 s28, s5, s28
    s_mul_i32 s24, s4, 17408
    s_add_u32 s24, s24, 0x10000
    s_mulk_i32 s27, 17
    s_lshl_b32 s26, s59, 9
    s_add_u32 s25, s27, s26
    s_add_u32 s25, s25, s24
    s_mov_b32 s31, 0
    s_lshl2_add_u32 s29, s4, s59
    s_mov_b32 s35, 0
    v_lshlrev_b32 v16, 7, v1
    s_waitcnt vmcnt(7)
    v_dot2_f32_bf16 v8, v44, s15, 0
    v_dot2_f32_bf16 v9, v44, v44, 0
    s_nop 1
    v_dot2c_f32_bf16 v8, s15, v45
    v_dot2c_f32_bf16 v9, v45, v45
    v_dot2c_f32_bf16 v8, s15, v46
    v_dot2c_f32_bf16 v9, v46, v46
    v_dot2c_f32_bf16 v8, s15, v47
    v_dot2c_f32_bf16 v9, v47, v47
    s_nop 2
    v_permlane32_swap_b32 v8, v9
    v_add_f32 v8, v8, v9
    v_mov_b32 v9, v8
    s_nop 1
    v_permlane16_swap_b32 v8, v9
    v_add_f32 v8, v8, v9
    s_nop 1
    v_add_f32_dpp v8, v8, v8 row_ror:8 row_mask:0xf bank_mask:0xf
    s_nop 1
    v_add_f32_dpp v8, v8, v8 row_ror:4 row_mask:0xf bank_mask:0xf
    s_nop 1
    v_add_f32_dpp v8, v8, v8 row_ror:2 row_mask:0xf bank_mask:0xf
    s_nop 1
    v_add_f32_dpp v9, v8, v8 row_ror:1 row_mask:0xf bank_mask:0xf
    v_add_f32_dpp v8, v8, v8 row_ror:1 row_mask:0xf bank_mask:0xf
    s_nop 1
    v_permlane32_swap_b32 v8, v9
    v_mul_f32 v8, 0x3b000000, v8
    v_mul_f32 v9, 0x3b000000, v9
    v_fma_f32 v9, -v8, v8, v9
    v_max_f32 v9, 0, v9
    v_cvt_pk_bf16_f32 v12, v8, v9
    v_lshlrev_b32 v17, 16, v12
    v_and_b32 v18, s58, v12
    v_add_f32 v18, 0x3727c5ac, v18
    v_cvt_pk_bf16_f32 v18, v18, v18
    v_and_b32 v18, s58, v18
    v_sqrt_f32 v18, v18
    s_nop 0
    v_cvt_pk_bf16_f32 v18, v18, v18
    v_and_b32 v18, s58, v18
    v_rcp_f32 v18, v18
    s_waitcnt vmcnt(6)
    v_lshlrev_b32 v8, 16, v132
    v_and_b32 v9, s58, v132
    v_sub_f32 v8, v8, v17
    v_sub_f32 v9, v9, v17
    v_cvt_pk_bf16_f32 v12, v8, v9
    v_lshlrev_b32 v8, 16, v12
    v_and_b32 v9, s58, v12
    v_mul_f32 v8, v8, v18
    v_mul_f32 v9, v9, v18
    v_cvt_pk_bf16_f32 v132, v8, v9
    s_waitcnt vmcnt(4)
    v_perm_b32 v60, v52, v48, s12
    v_perm_b32 v61, v52, v48, s13
    v_perm_b32 v62, v53, v49, s12
    v_perm_b32 v63, v53, v49, s13
    v_perm_b32 v64, v54, v50, s12
    v_perm_b32 v65, v54, v50, s13
    v_perm_b32 v66, v55, v51, s12
    v_perm_b32 v67, v55, v51, s13
    v_dot2_f32_bf16 v84, v60, v132, 0
    v_dot2_f32_bf16 v85, v61, v132, 0
    v_dot2_f32_bf16 v86, v62, v132, 0
    v_dot2_f32_bf16 v87, v63, v132, 0
    v_dot2_f32_bf16 v88, v64, v132, 0
    v_dot2_f32_bf16 v89, v65, v132, 0
    v_dot2_f32_bf16 v90, v66, v132, 0
    v_dot2_f32_bf16 v91, v67, v132, 0
    v_permlane32_swap_b32 v84, v88
    v_permlane32_swap_b32 v85, v89
    v_permlane32_swap_b32 v86, v90
    v_permlane32_swap_b32 v87, v91
    v_add_f32 v84, v84, v88
    v_add_f32 v85, v85, v89
    v_add_f32 v86, v86, v90
    v_add_f32 v87, v87, v91
    s_nop 0
    v_permlane16_swap_b32 v84, v86
    v_permlane16_swap_b32 v85, v87
    v_add_f32 v84, v84, v86
    v_add_f32 v85, v85, v87
    s_nop 0
    v_add_f32_dpp v84, v84, v84 row_ror:8 row_mask:0xf bank_mask:0xf
    v_add_f32_dpp v85, v85, v85 row_ror:8 row_mask:0xf bank_mask:0xf
    ds_write_b64 v13, v[84:85] offset:0
    s_waitcnt lgkmcnt(0)
    s_add_u32 s6, s6, 1
    s_barrier
    s_lshl4_add_u32 s34, s6, s34
    v_mov_b32 v98, s6
    v_mov_b32 v99, s7
    s_cmp_lg_u32 s3, 0
    s_cbranch_scc1 L_NOPUB1
    ds_read2_b64 v[84:87], v14 offset0:0 offset1:32
    ds_read2_b64 v[88:91], v14 offset0:64 offset1:96
    v_mov_b32 v100, s34
    s_add_u32 s26, s25, 0x24000
    s_waitcnt lgkmcnt(0)
    v_pk_add_f32 v[84:85], v[84:85], v[86:87]
    v_pk_add_f32 v[88:89], v[88:89], v[90:91]
    v_pk_add_f32 v[96:97], v[84:85], v[88:89]
    v_pk_add_f32 v[84:85], v[84:85], v[88:89]
    s_nop 1
    v_permlane32_swap_b32 v96, v84
    v_permlane32_swap_b32 v97, v85
    v_pk_add_f32 v[96:97], v[96:97], v[84:85]
    s_mov_b32 exec_hi, 0
    buffer_store_dwordx4 v[96:99], v20, s[16:19], s25 offen
    buffer_store_dword v100, v16, s[16:19], s28 offen
    buffer_store_dwordx4 v[96:99], v20, s[16:19], s26 offen sc1
    s_mov_b64 exec, -1
L_NOPUB1:
    s_barrier
    v_xor_b32 v19, 0xc0, v23
    buffer_load_dwordx4 v19, s[44:47], s99 offen offset:3072 nt lds
    s_mov_b32 m0, s98
    s_add_u32 s98, s98, s100
    buffer_load_dwordx4 v138, s[48:51], s99 offen nt lds
    s_add_u32 s99, s99, s100
    s_mov_b32 m0, s98
    s_add_u32 s98, s98, s100
    buffer_load_dwordx4 v138, s[48:51], s99 offen nt lds
    s_add_u32 s99, s99, s100
    s_cmp_lt_u32 s5, 16
    s_cbranch_scc0 L_LA_G
    s_lshl_b32 s97, s29, 9
    s_add_u32 s97, s97, s32
    s_lshl_b32 s97, s97, 8
    v_lshl_or_b32 v10, v10, 10, v128
    s_lshl_b32 s30, s100, 2
    s_mov_b64 s[60:61], s[56:57]
    s_mov_b64 s[62:63], s[56:57]
    s_branch L_LA_GO
L_LA_G:
    s_max_u32 s26, s4, 4
    s_sub_u32 s26, s29, s26
    s_lshr_b32 s35, s4, 2
    s_add_u32 s35, s35, s59
    s_cmp_eq_u32 s35, 8
    s_cselect_b32 s35, 2, 1
    s_lshl2_add_u32 s29, s26, s32
    s_mul_i32 s97, s32, 3584
    s_add_u32 s97, s97, s26
    s_lshl_b32 s97, s97, 7
    v_and_b32 v128, 0x70, v128
    s_movk_i32 s26, 3584
    v_mad_u32_u24 v10, v10, s26, v128
    s_lshl_b32 s30, s26, 5
L_LA_GO:
    v_cmp_lt_u32 vcc, 7, v11
    v_add_u32 v128, s97, v10
    v_mov_b32 v129, 0
    v_lshl_add_u64 v[136:137], v[128:129], 0, s[60:61]
    v_lshl_add_u64 v[130:131], v[128:129], 0, s[62:63]
    v_cndmask_b32 v136, v136, v130, vcc
    v_cndmask_b32 v137, v137, v131, vcc
    v_mov_b32 v103, s6
    v_bfe_u32 v9, v1, 2, 2
    v_bfe_u32 v10, v1, 2, 3
    v_xor_b32 v10, v10, v3
    v_and_b32 v14, 3, v1
    v_lshl_or_b32 v10, v10, 2, v14
    v_lshl_or_b32 v10, v9, 5, v10
    v_lshl_or_b32 v10, v6, 8, v10
    v_lshlrev_b32 v26, 3, v10
    v_and_b32 v10, 48, v1
    s_movk_i32 s26, 272
    v_mad_u32_u24 v27, v14, s26, v10
    v_mad_u32_u24 v24, v9, s26, v10
    v_lshrrev_b32 v16, 1, v0
    v_and_b32 v16, 0xf8, v16
    v_mad_u32_u24 v16, v14, s26, v16
    v_lshl_or_b32 v12, v3, 5, v15
    v_mul_u32_u24 v9, 8704, v4
    v_lshl_add_u32 v8, v12, 4, v9
    s_add_u32 s25, s24, 4352
    v_lshl_or_b32 v9, v12, 1, v4
    v_and_b32 v12, 6, v3
    v_lshl_add_u32 v9, v12, 2, v9
    v_lshlrev_b32 v9, 1, v9
    v_xor_b32 v125, 64, v124
    v_xor_b32 v126, 0x80, v124
    v_xor_b32 v127, 64, v126
    v_lshlrev_b32 v15, 5, v14
    v_lshl_add_u32 v11, v3, 2, v15
    v_lshlrev_b32 v17, 5, v6
    v_lshl_or_b32 v18, v6, 15, v25
    s_lshl_b32 s28, s4, 5
    s_add_u32 s28, s28, s3
    s_lshl_b32 s28, s28, 5
    s_add_u32 s28, s28, s5
    s_add_u32 s28, s28, s100
    s_lshl_b32 s28, s28, 7
    s_mov_b32 s96, 0
    s_cmp_lg_u32 s3, 7
    s_cbranch_scc1 L_FL_DONE
    s_movk_i32 s14, 31
    s_mov_b32 s8, s34
    s_mov_b32 s9, s34
L_FL:
    s_load_dwordx16 s[64:79], s[10:11], 0
    s_load_dwordx16 s[80:95], s[10:11], 64
    s_waitcnt lgkmcnt(0)
    s_cmp_eq_u64 s[64:65], s[8:9]
    s_cbranch_scc0 L_FL_NO
    s_cmp_eq_u64 s[66:67], s[8:9]
    s_cbranch_scc0 L_FL_NO
    s_cmp_eq_u64 s[68:69], s[8:9]
    s_cbranch_scc0 L_FL_NO
    s_cmp_eq_u64 s[70:71], s[8:9]
    s_cbranch_scc0 L_FL_NO
    s_cmp_eq_u64 s[72:73], s[8:9]
    s_cbranch_scc0 L_FL_NO
    s_cmp_eq_u64 s[74:75], s[8:9]
    s_cbranch_scc0 L_FL_NO
    s_cmp_eq_u64 s[76:77], s[8:9]
    s_cbranch_scc0 L_FL_NO
    s_cmp_eq_u64 s[78:79], s[8:9]
    s_cbranch_scc0 L_FL_NO
    s_cmp_eq_u64 s[80:81], s[8:9]
    s_cbranch_scc0 L_FL_NO
    s_cmp_eq_u64 s[82:83], s[8:9]
    s_cbranch_scc0 L_FL_NO
    s_cmp_eq_u64 s[84:85], s[8:9]
    s_cbranch_scc0 L_FL_NO
    s_cmp_eq_u64 s[86:87], s[8:9]
    s_cbranch_scc0 L_FL_NO
    s_cmp_eq_u64 s[88:89], s[8:9]
    s_cbranch_scc0 L_FL_NO
    s_cmp_eq_u64 s[90:91], s[8:9]
    s_cbranch_scc0 L_FL_NO
    s_cmp_eq_u64 s[92:93], s[8:9]
    s_cbranch_scc0 L_FL_NO
    s_cmp_eq_u64 s[94:95], s[8:9]
    s_cbranch_scc0 L_FL_NO
    s_mov_b32 s96, 1
    s_branch L_FL_W
L_FL_NO:
    s_addk_i32 s10, 128
    s_sub_u32 s14, s14, 1
    s_cbranch_scc0 L_FL
L_FL_W:
    v_mov_b32 v112, s96
    ds_write_b32 v2, v112 offset:5760
L_FL_DONE:
    s_barrier
    buffer_load_dwordx4 v[104:107], v8, s[16:19], s24 offen sc1
    buffer_load_dwordx4 v[108:111], v8, s[16:19], s25 offen sc1
    s_barrier
    s_mov_b32 m0, s98
    s_add_u32 s98, s98, s100
    buffer_load_dwordx4 v138, s[48:51], s99 offen nt lds
    s_add_u32 s99, s99, s100
    s_mov_b32 m0, s98
    s_add_u32 s98, s98, s100
    buffer_load_dwordx4 v138, s[48:51], s99 offen nt lds
    s_add_u32 s99, s99, s100
    buffer_load_dwordx4 v[120:123], v18, s[16:19], s28 offen sc1
    s_waitcnt vmcnt(3)
L_N3D:
    ds_read_b128 v[28:31], v124 offset:40960
    ds_read_b128 v[32:35], v125 offset:40960
    ds_read_b128 v[36:39], v126 offset:40960
    ds_read_b128 v[40:43], v127 offset:40960
    v_xor_b32 v84, s6, v106
    v_xor_b32 v88, s7, v107
    v_or_b32 v84, v84, v88
    v_xor_b32 v85, s6, v110
    v_xor_b32 v89, s7, v111
    v_or_b32 v85, v85, v89
    v_or_b32 v84, v84, v85
    v_cmp_ne_u32 vcc, 0, v84
    s_cbranch_vccnz L_E1_RETRY
L_E1_OK:
    v_pk_add_f32 v[104:105], v[104:105], v[108:109]
    s_cmp_gt_u32 s35, 0
    s_nop 0
    v_permlane32_swap_b32 v104, v105
    v_add_f32 v104, v104, v105
    v_cvt_pk_bf16_f32 v104, v104, v104
    ds_write_b16 v9, v104 offset:2048
    s_cbranch_scc1 N1
    s_mov_b32 m0, s33
    s_add_u32 s33, s33, s100
    global_load_lds_dwordx4 v[136:137], off nt
    v_lshl_add_u64 v[136:137], v[136:137], 0, s[30:31]
    s_mov_b32 m0, s33
    s_add_u32 s33, s33, s100
    global_load_lds_dwordx4 v[136:137], off nt
    v_lshl_add_u64 v[136:137], v[136:137], 0, s[30:31]
N1:
    s_waitcnt lgkmcnt(0)
    s_barrier
    ds_read_b128 v[44:47], v27 offset:2048
    ds_read_b128 v[48:51], v27 offset:2112
    ds_read_b128 v[52:55], v27 offset:2176
    ds_read_b128 v[56:59], v27 offset:2240
    ds_read_b32 v68, v2 offset:5760
    v_mov_b32 v128, 0x3db504f3
    s_waitcnt lgkmcnt(4)
    v_mfma_f32_16x16x32_bf16 v[92:95], v[28:31], v[44:47], 0
    s_waitcnt lgkmcnt(3)
    v_mfma_f32_16x16x32_bf16 v[92:95], v[32:35], v[48:51], v[92:95]
    s_waitcnt lgkmcnt(2)
    v_mfma_f32_16x16x32_bf16 v[92:95], v[36:39], v[52:55], v[92:95]
    s_waitcnt lgkmcnt(1)
    v_mfma_f32_16x16x32_bf16 v[92:95], v[40:43], v[56:59], v[92:95]
    s_waitcnt lgkmcnt(0)
    v_readfirstlane_b32 s96, v68
    s_nop 5
    v_cvt_pk_bf16_f32 v12, v92, v93
    v_cvt_pk_bf16_f32 v13, v94, v95
    v_lshlrev_b32 v84, 16, v12
    v_and_b32 v85, s58, v12
    v_lshlrev_b32 v86, 16, v13
    v_and_b32 v87, s58, v13
    v_mul_f32 v84, v128, v84
    v_mul_f32 v85, v128, v85
    v_mul_f32 v86, v128, v86
    v_mul_f32 v87, v128, v87
    v_cvt_pk_bf16_f32 v12, v84, v85
    v_cvt_pk_bf16_f32 v13, v86, v87
    v_lshlrev_b32 v84, 16, v12
    v_and_b32 v85, s58, v12
    v_lshlrev_b32 v86, 16, v13
    v_and_b32 v87, s58, v13
    v_max3_f32 v12, v84, v85, v86
    v_max_f32 v12, v12, v87
    v_mov_b32 v13, v12
    s_nop 1
    v_permlane16_swap_b32 v12, v13
    v_max_f32 v12, v12, v13
    v_mov_b32 v13, v12
    s_nop 1
    v_permlane32_swap_b32 v12, v13
    v_max_f32 v12, v12, v13
    ds_write_b32 v11, v12 offset:4224
    s_cmp_lg_u32 s35, 0
    s_waitcnt lgkmcnt(0)
    s_barrier
    ds_read_b128 v[60:63], v15 offset:4224
    ds_read_b128 v[64:67], v15 offset:4240
    s_cbranch_scc1 N2
    s_mov_b32 m0, s33
    s_add_u32 s33, s33, s100
    global_load_lds_dwordx4 v[136:137], off nt
    v_lshl_add_u64 v[136:137], v[136:137], 0, s[30:31]
    s_mov_b32 m0, s33
    s_add_u32 s33, s33, s100
    global_load_lds_dwordx4 v[136:137], off nt
    v_lshl_add_u64 v[136:137], v[136:137], 0, s[30:31]
N2:
    s_waitcnt lgkmcnt(0)
    v_max3_f32 v12, v60, v61, v62
    v_max3_f32 v13, v63, v64, v65
    v_max3_f32 v12, v12, v66, v67
    v_max_f32 v12, v12, v13
    v_mul_f32 v128, s101, v12
    v_fma_f32 v84, v84, s101, -v128
    v_fma_f32 v85, v85, s101, -v128
    v_fma_f32 v86, v86, s101, -v128
    v_fma_f32 v87, v87, s101, -v128
    v_exp_f32 v84, v84
    v_exp_f32 v85, v85
    v_exp_f32 v86, v86
    v_exp_f32 v87, v87
    v_lshrrev_b32 v129, 2, v10
    v_cvt_pk_bf16_f32 v88, v84, v85
    v_add_f32 v12, v84, v85
    v_cvt_pk_bf16_f32 v89, v86, v87
    v_add_f32 v13, v86, v87
    ds_write_b64 v16, v[88:89] offset:3136
    ds_bpermute_b32 v112, v129, v128
    v_add_f32 v12, v12, v13
    v_mov_b32 v13, v12
    s_nop 1
    v_permlane16_swap_b32 v12, v13
    v_add_f32 v12, v12, v13
    v_mov_b32 v13, v12
    s_nop 1
    v_permlane32_swap_b32 v12, v13
    v_add_f32 v12, v12, v13
    ds_write_b32 v11, v12 offset:4352
    s_cmp_eq_u32 s35, 0
    s_waitcnt vmcnt(5)
    s_cbranch_scc1 L_WV
    s_waitcnt vmcnt(1)
L_WV:
    s_waitcnt lgkmcnt(0)
    s_barrier
    ds_read_b128 v[84:87], v17 offset:4352
    ds_read_b128 v[88:91], v17 offset:4368
    ds_read_b128 v[44:47], v24 offset:3136
    ds_read_b64_tr_b16 v[60:61], v26 offset:8192
    ds_read_b64_tr_b16 v[62:63], v26 offset:9216
    ds_read_b128 v[48:51], v24 offset:3200
    ds_read_b64_tr_b16 v[64:65], v26 offset:16384
    ds_read_b64_tr_b16 v[66:67], v26 offset:17408
    ds_read_b128 v[52:55], v24 offset:3264
    ds_read_b64_tr_b16 v[68:69], v26 offset:24576
    ds_read_b64_tr_b16 v[70:71], v26 offset:25600
    ds_read_b128 v[56:59], v24 offset:3328
    ds_read_b64_tr_b16 v[72:73], v26 offset:32768
    ds_read_b64_tr_b16 v[74:75], v26 offset:33792
    s_lshl3_add_u32 s24, s29, s3
    s_addk_i32 s24, 256
    s_lshl_b32 s24, s24, 12
    s_waitcnt lgkmcnt(12)
    v_pk_add_f32 v[84:85], v[84:85], v[86:87]
    v_pk_add_f32 v[88:89], v[88:89], v[90:91]
    v_pk_add_f32 v[84:85], v[84:85], v[88:89]
    v_add_f32 v84, v84, v85
    s_waitcnt lgkmcnt(9)
    v_mfma_f32_16x16x32_bf16 v[92:95], v[44:47], v[60:63], 0
    s_waitcnt lgkmcnt(6)
    v_mfma_f32_16x16x32_bf16 v[92:95], v[48:51], v[64:67], v[92:95]
    s_waitcnt lgkmcnt(3)
    v_mfma_f32_16x16x32_bf16 v[92:95], v[52:55], v[68:71], v[92:95]
    s_waitcnt lgkmcnt(0)
    v_mfma_f32_16x16x32_bf16 v[92:95], v[56:59], v[72:75], v[92:95]
    v_log_f32 v102, v84
    v_rcp_f32 v84, v84
    v_lshl_or_b32 v11, v4, 3, v7
    v_add_f32 v102, v102, v112
    v_lshl_or_b32 v11, v3, 4, v11
    v_lshlrev_b32 v11, 1, v11
    s_nop 1
    v_mul_f32 v100, v92, v84
    s_nop 1
    v_mov_b32_dpp v101, v100 row_ror:8 row_mask:0xf bank_mask:0xf
    s_mov_b32 exec_lo, 0xff00ff
    s_mov_b32 exec_hi, exec_lo
    s_cmp_eq_u32 s96, 0
    s_cbranch_scc1 S3
    buffer_store_dwordx4 v[100:103], v18, s[16:19], s28 offen
    s_branch S4
S3:
    buffer_store_dwordx4 v[100:103], v18, s[16:19], s28 offen sc1
S4:
    s_mov_b64 exec, -1
    s_cmp_eq_u32 s35, 1
    s_cbranch_scc1 L_GT
    s_cmp_eq_u32 s35, 2
    s_cbranch_scc1 L_FIN0
    buffer_load_dwordx4 v[104:107], v20, s[16:19], s24 offen sc1
    buffer_load_dwordx4 v[108:111], v20, s[16:19], s24 offen offset:1024 sc1
    buffer_load_dwordx4 v[112:115], v20, s[16:19], s24 offen offset:2048 sc1
    buffer_load_dwordx4 v[116:119], v20, s[16:19], s24 offen offset:3072 sc1
    v_add_u32 v9, 0x12000, v26
    s_lshl3_add_u32 s28, s32, s3
    s_lshl_b32 s28, s28, 5
    s_add_u32 s28, s28, s29
    s_mulk_i32 s28, 128
    s_add_u32 s28, s28, 0x200000
    s_waitcnt vmcnt(5)
    s_barrier
    ds_read_b64_tr_b16 v[28:29], v9 offset:0
    ds_read_b64_tr_b16 v[30:31], v9 offset:1024
    ds_read_b64_tr_b16 v[32:33], v9 offset:8192
    ds_read_b64_tr_b16 v[34:35], v9 offset:9216
    ds_read_b64_tr_b16 v[36:37], v9 offset:16384
    ds_read_b64_tr_b16 v[38:39], v9 offset:17408
    ds_read_b64_tr_b16 v[40:41], v9 offset:24576
    ds_read_b64_tr_b16 v[42:43], v9 offset:25600
    s_mov_b32 s14, 2097152
    s_branch C7
P5:
    s_mov_b64 exec, s[40:41]
    s_cbranch_execz K8
    buffer_load_dwordx4 v[104:107], v20, s[16:19], s24 offen sc1
K8:
    s_mov_b64 exec, s[42:43]
    s_cbranch_execz K9
    buffer_load_dwordx4 v[108:111], v20, s[16:19], s24 offen offset:1024 sc1
K9:
    s_mov_b64 exec, s[44:45]
    s_cbranch_execz K10
    buffer_load_dwordx4 v[112:115], v20, s[16:19], s24 offen offset:2048 sc1
K10:
    s_mov_b64 exec, s[46:47]
    s_cbranch_execz K11
    buffer_load_dwordx4 v[116:119], v20, s[16:19], s24 offen offset:3072 sc1
K11:
    s_mov_b64 exec, -1
C7:
    s_waitcnt vmcnt(0)
    v_xor_b32 v84, s6, v107
    v_xor_b32_dpp v88, v106, v106 quad_perm:[1,0,3,2] row_mask:0xf bank_mask:0xf
    v_or_b32 v84, v84, v88
    v_xor_b32 v85, s6, v111
    v_xor_b32_dpp v89, v110, v110 quad_perm:[1,0,3,2] row_mask:0xf bank_mask:0xf
    v_or_b32 v85, v85, v89
    v_xor_b32 v86, s6, v115
    v_xor_b32_dpp v90, v114, v114 quad_perm:[1,0,3,2] row_mask:0xf bank_mask:0xf
    v_or_b32 v86, v86, v90
    v_xor_b32 v87, s6, v119
    v_xor_b32_dpp v91, v118, v118 quad_perm:[1,0,3,2] row_mask:0xf bank_mask:0xf
    v_or_b32 v87, v87, v91
    v_cmp_ne_u32 s[40:41], 0, v84
    v_cmp_ne_u32 s[42:43], 0, v85
    v_cmp_ne_u32 s[44:45], 0, v86
    v_cmp_ne_u32 s[46:47], 0, v87
    v_max3_f32 v13, v106, v110, v114
    v_max_f32 v13, v13, v118
    s_sub_u32 s14, s14, 1
    s_cbranch_scc1 D6
    s_or_b64 vcc, s[40:41], s[42:43]
    s_or_b64 vcc, vcc, s[44:45]
    s_or_b64 vcc, vcc, s[46:47]
    s_cbranch_scc1 P5
D6:
    v_max_f32_dpp v13, v13, v13 row_ror:8 row_mask:0xf bank_mask:0xf
    v_mov_b32 v14, v13
    s_nop 1
    v_permlane16_swap_b32 v13, v14
    v_max_f32 v13, v13, v14
    v_mov_b32 v14, v13
    s_nop 1
    v_permlane32_swap_b32 v13, v14
    v_max_f32 v13, v13, v14
    v_sub_f32 v106, v106, v13
    v_sub_f32 v110, v110, v13
    v_sub_f32 v114, v114, v13
    v_sub_f32 v118, v118, v13
    v_exp_f32 v106, v106
    v_exp_f32 v110, v110
    v_exp_f32 v114, v114
    v_exp_f32 v118, v118
    v_mul_f32 v104, v106, v104
    v_mul_f32 v105, v106, v105
    v_fmac_f32 v104, v110, v108
    v_fmac_f32 v105, v110, v109
    v_add_f32 v106, v106, v110
    v_fmac_f32 v104, v114, v112
    v_fmac_f32 v105, v114, v113
    v_add_f32 v106, v106, v114
    v_fmac_f32 v104, v118, v116
    v_fmac_f32 v105, v118, v117
    v_add_f32 v106, v106, v118
    v_mov_b32 v107, v106
    v_permlane32_swap_b32 v104, v105
    s_nop 0
    v_permlane32_swap_b32 v106, v107
    v_add_f32 v104, v104, v105
    v_add_f32 v106, v106, v107
    v_mov_b32 v105, v104
    v_mov_b32 v107, v106
    s_nop 0
    v_permlane16_swap_b32 v104, v105
    v_permlane16_swap_b32 v106, v107
    v_add_f32 v106, v106, v107
    v_add_f32 v104, v104, v105
    s_nop 0
    v_add_f32_dpp v106, v106, v106 row_ror:8 row_mask:0xf bank_mask:0xf
    v_add_f32_dpp v104, v104, v104 row_ror:8 row_mask:0xf bank_mask:0xf
    v_rcp_f32 v106, v106
    s_nop 0
    v_mul_f32 v104, v104, v106
    v_cvt_pk_bf16_f32 v104, v104, v104
    ds_write_b16 v11, v104 offset:5504
    s_waitcnt lgkmcnt(0)
    s_barrier
    ds_read_b128 v[44:47], v10 offset:5504
    ds_read_b128 v[48:51], v10 offset:5568
    ds_read_b128 v[52:55], v10 offset:5632
    ds_read_b128 v[56:59], v10 offset:5696
    s_waitcnt lgkmcnt(3)
    v_mfma_f32_16x16x32_bf16 v[92:95], v[44:47], v[28:31], 0
    s_waitcnt lgkmcnt(2)
    v_mfma_f32_16x16x32_bf16 v[92:95], v[48:51], v[32:35], v[92:95]
    s_waitcnt lgkmcnt(1)
    v_mfma_f32_16x16x32_bf16 v[92:95], v[52:55], v[36:39], v[92:95]
    s_waitcnt lgkmcnt(0)
    v_mfma_f32_16x16x32_bf16 v[92:95], v[56:59], v[40:43], v[92:95]
    s_cmp_eq_u32 s32, 0
    s_nop 6
    v_mov_b32_dpp v97, v92 row_ror:8 row_mask:0xf bank_mask:0xf
    v_mov_b32 v96, v93
    s_mov_b64 exec, 0xff
    buffer_store_dwordx4 v[96:99], v20, s[16:19], s28 offen sc1
    s_mov_b64 exec, -1
    s_cbranch_scc1 L_RED
L_FIN0:
    s_endpgm
L_END0:
    s_endpgm
L_GT:
    s_barrier
    s_mov_b32 m0, s33
    s_add_u32 s33, s33, s100
    global_load_lds_dwordx4 v[136:137], off nt
    v_lshl_add_u64 v[136:137], v[136:137], 0, s[30:31]
    s_mov_b32 m0, s33
    s_add_u32 s33, s33, s100
    global_load_lds_dwordx4 v[136:137], off nt
    v_lshl_add_u64 v[136:137], v[136:137], 0, s[30:31]
    s_mov_b32 m0, s33
    s_add_u32 s33, s33, s100
    global_load_lds_dwordx4 v[136:137], off nt
    v_lshl_add_u64 v[136:137], v[136:137], 0, s[30:31]
    s_mov_b32 m0, s33
    s_add_u32 s33, s33, s100
    global_load_lds_dwordx4 v[136:137], off nt
    v_lshl_add_u64 v[136:137], v[136:137], 0, s[30:31]
    s_mul_i32 s54, s39, 14
    s_mov_b32 s55, s39
    s_lshl_b32 s26, s3, 5
    s_and_b32 s27, s26, 0x80
    s_lshl_b32 s26, s26, 1
    s_and_b32 s26, s26, 64
    s_or_b32 s26, s26, s27
    v_xor_b32 v19, s26, v20
    s_add_u32 s26, s3, 20
    s_lshl_b32 m0, s26, 11
    s_lshl3_add_u32 s27, s29, s3
    s_lshl_b32 s27, s27, 11
    buffer_load_dwordx4 v19, s[52:55], s27 offen nt lds
    v_xor_b32 v19, 32, v19
    buffer_load_dwordx4 v19, s[52:55], s27 offen offset:1024 nt lds
    s_branch L_ROLE_G
L_PAGE0_END:
.if (L_PAGE0_END - sequential_preLN__sliding_block_cached__glu_gated_reglu__decode_kernel) > 4096
.error "page 0 overflow"
.endif
.fill (4096 - (L_PAGE0_END - sequential_preLN__sliding_block_cached__glu_gated_reglu__decode_kernel)) / 4, 4, 0xbf800000
L_ROLE_G:
    s_lshl_b32 s28, s29, 12
    s_add_u32 s28, s28, 0x80000
    v_lshlrev_b32 v13, 4, v0
    v_and_b32 v13, 0xff0, v13
    buffer_load_dwordx4 v[120:123], v13, s[16:19], s28 offen sc1
    s_lshl_b32 s26, s32, 8
    buffer_load_ushort v132, v11, s[36:39], s26 offen
    s_and_b32 s59, s3, 1
    s_lshl_b32 s59, s59, 2
    s_lshr_b32 s27, s3, 1
    s_or_b32 s26, s59, s27
    s_xor_b32 s26, s26, s3
    s_lshl_b32 s26, s26, 5
    v_xor_b32 v9, s26, v26
    v_add_u32 v9, 0x12000, v9
    s_andn2_b32 s33, s29, 3
    s_add_u32 s33, s33, s27
    s_lshl_b32 s33, s33, 12
    s_add_u32 s33, s33, 0x80000
    s_add_u32 s59, s59, s32
    v_lshrrev_b32 v12, 1, v7
    v_lshlrev_b32 v12, 8, v12
    v_and_b32 v14, 1, v1
    v_lshl_or_b32 v12, v14, 4, v12
    v_lshl_add_u32 v12, s59, 5, v12
    s_lshl_b32 s59, s59, 4
    s_add_u32 s59, s59, 2048
    v_mov_b32 v15, s59
    v_cmp_eq_u32 s[10:11], 8, v1
    v_and_b32 v14, 8, v1
    v_cmp_ne_u32 s[8:9], 0, v14
    v_cndmask_b32 v27, v12, v15, s[10:11]
    s_add_u32 s59, s33, 1024
    v_and_b32 v22, 14, v1
    v_lshlrev_b32 v22, 3, v22
    s_lshl3_add_u32 s24, s32, s3
    s_mul_i32 s24, s24, 4096
    s_add_u32 s24, s24, 0x200000
    s_add_u32 s48, s24, 1024
    s_add_u32 s49, s24, 2048
    s_add_u32 s50, s24, 3072
    v_lshrrev_b32 v8, 3, v1
    v_mul_u32_u24 v8, 128, v8
    v_add_u32 v8, v8, v25
    s_lshl_b32 s25, s3, 9
    s_add_u32 s25, s25, s29
    s_mul_i32 s25, s25, 128
    s_add_u32 s25, s25, 0x380000
    v_mul_u32_u24 v24, 16384, v6
    v_add_u32 v24, v24, v25
    v_bfe_u32 v14, v1, 3, 1
    v_lshl_or_b32 v14, v6, 1, v14
    v_bfe_u32 v15, v1, 2, 1
    v_and_b32 v23, 3, v14
    v_lshl_or_b32 v23, v15, 2, v23
    v_lshl_or_b32 v14, v15, 3, v14
    v_lshlrev_b32 v15, 2, v3
    v_xor_b32 v23, v23, v15
    v_lshlrev_b32 v23, 5, v23
    v_lshl_or_b32 v23, v14, 10, v23
    v_and_b32 v14, 3, v1
    v_lshl_or_b32 v23, v14, 3, v23
    v_cmp_eq_u32 s[98:99], 1, v6
    v_mov_b32 v124, s15
    v_mov_b32 v125, s15
    v_mov_b32 v126, s15
    v_mov_b32 v127, s15
    s_waitcnt vmcnt(0)
    s_barrier
    buffer_load_dwordx4 v[104:107], v8, s[16:19], s24 offen sc1
    buffer_load_dwordx4 v[108:111], v8, s[16:19], s48 offen sc1
    buffer_load_dwordx4 v[112:115], v8, s[16:19], s49 offen sc1
    buffer_load_dwordx4 v[116:119], v8, s[16:19], s50 offen sc1
    ds_read_b64_tr_b16 v[28:29], v9 offset:0
    ds_read_b64_tr_b16 v[30:31], v9 offset:1024
    ds_read_b64_tr_b16 v[32:33], v9 offset:8192
    ds_read_b64_tr_b16 v[34:35], v9 offset:9216
    ds_read_b64_tr_b16 v[36:37], v9 offset:16384
    ds_read_b64_tr_b16 v[38:39], v9 offset:17408
    ds_read_b64_tr_b16 v[40:41], v9 offset:24576
    ds_read_b64_tr_b16 v[42:43], v9 offset:25600
    ds_read_b64_tr_b16 v[76:77], v23 offset:40960
    v_xor_b32 v14, 32, v23
    ds_read_b64_tr_b16 v[78:79], v14 offset:40960
    v_xor_b32 v14, 64, v23
    ds_read_b64_tr_b16 v[80:81], v14 offset:40960
    v_xor_b32 v14, 96, v23
    ds_read_b64_tr_b16 v[82:83], v14 offset:40960
    v_lshlrev_b32 v132, 16, v132
    s_waitcnt lgkmcnt(0)
    v_mfma_f32_16x16x32_bf16 v[92:95], v[124:127], v[28:31], 0
    v_mfma_f32_16x16x32_bf16 v[92:95], v[124:127], v[32:35], v[92:95]
    v_mfma_f32_16x16x32_bf16 v[92:95], v[124:127], v[36:39], v[92:95]
    v_mfma_f32_16x16x32_bf16 v[92:95], v[124:127], v[40:43], v[92:95]
    s_nop 7
    v_mov_b32 v96, v92
    v_mov_b32_dpp v97, v92 row_ror:8 row_mask:0xf bank_mask:0xf
    s_mov_b64 exec, 0xff
    s_cmp_eq_u32 s96, 0
    s_cbranch_scc1 S12
    buffer_store_dwordx4 v[96:99], v12, s[16:19], s59 offen
    s_branch S13
S12:
    buffer_store_dwordx4 v[96:99], v12, s[16:19], s59 offen sc1
S13:
    s_mov_b64 exec, -1
    s_mov_b32 s14, 2097152
    s_branch C16
P14:
    s_mov_b64 exec, s[40:41]
    s_cbranch_execz K17
    buffer_load_dwordx4 v[104:107], v8, s[16:19], s24 offen sc1
K17:
    s_mov_b64 exec, s[42:43]
    s_cbranch_execz K18
    buffer_load_dwordx4 v[108:111], v8, s[16:19], s48 offen sc1
K18:
    s_mov_b64 exec, s[44:45]
    s_cbranch_execz K19
    buffer_load_dwordx4 v[112:115], v8, s[16:19], s49 offen sc1
K19:
    s_mov_b64 exec, s[46:47]
    s_cbranch_execz K20
    buffer_load_dwordx4 v[116:119], v8, s[16:19], s50 offen sc1
K20:
    s_mov_b64 exec, -1
C16:
    s_waitcnt vmcnt(0)
    v_xor_b32 v84, s6, v106
    v_xor_b32 v88, s7, v107
    v_or_b32 v84, v84, v88
    v_xor_b32 v85, s6, v110
    v_xor_b32 v89, s7, v111
    v_or_b32 v85, v85, v89
    v_xor_b32 v86, s6, v114
    v_xor_b32 v90, s7, v115
    v_or_b32 v86, v86, v90
    v_xor_b32 v87, s6, v118
    v_xor_b32 v91, s7, v119
    v_or_b32 v87, v87, v91
    v_cmp_ne_u32 s[40:41], 0, v84
    v_cmp_ne_u32 s[42:43], 0, v85
    v_cmp_ne_u32 s[44:45], 0, v86
    v_cmp_ne_u32 s[46:47], 0, v87
    s_sub_u32 s14, s14, 1
    s_cbranch_scc1 D15
    s_or_b64 vcc, s[40:41], s[42:43]
    s_or_b64 vcc, vcc, s[44:45]
    s_or_b64 vcc, vcc, s[46:47]
    s_cbranch_scc1 P14
D15:
    v_pk_add_f32 v[104:105], v[104:105], v[108:109]
    v_pk_add_f32 v[112:113], v[112:113], v[116:117]
    v_pk_add_f32 v[104:105], v[104:105], v[112:113]
    s_nop 1
    v_permlane32_swap_b32 v104, v105
    v_add_f32 v104, v104, v105
    v_mov_b32 v105, v104
    s_nop 1
    v_permlane16_swap_b32 v104, v105
    v_add_f32 v104, v104, v105
    s_nop 1
    v_add_f32_dpp v104, v104, v104 row_ror:8 row_mask:0xf bank_mask:0xf
    v_cvt_pk_bf16_f32 v104, v104, v104
    v_and_b32 v104, s58, v104
    v_add_f32 v104, v104, v132
    v_cvt_pk_bf16_f32 v104, v104, v104
    ds_write_b16 v11, v104 offset:5504
    s_waitcnt lgkmcnt(0)
    s_barrier
    ds_read_b128 v[44:47], v10 offset:5504
    ds_read_b128 v[48:51], v10 offset:5568
    ds_read_b128 v[52:55], v10 offset:5632
    ds_read_b128 v[56:59], v10 offset:5696
    s_bitcmp1_b32 s3, 0
    s_cbranch_scc1 L_ST_UP
    s_waitcnt lgkmcnt(3)
    v_mfma_f32_16x16x32_bf16 v[92:95], v[44:47], v[28:31], 0
    v_mfma_f32_16x16x32_bf16 v[84:87], v[44:47], v[44:47], 0
    s_waitcnt lgkmcnt(2)
    v_mfma_f32_16x16x32_bf16 v[92:95], v[48:51], v[32:35], v[92:95]
    v_mfma_f32_16x16x32_bf16 v[84:87], v[48:51], v[48:51], v[84:87]
    s_waitcnt lgkmcnt(1)
    v_mfma_f32_16x16x32_bf16 v[92:95], v[52:55], v[36:39], v[92:95]
    v_mfma_f32_16x16x32_bf16 v[84:87], v[52:55], v[52:55], v[84:87]
    s_waitcnt lgkmcnt(0)
    v_mfma_f32_16x16x32_bf16 v[92:95], v[56:59], v[40:43], v[92:95]
    v_mfma_f32_16x16x32_bf16 v[84:87], v[56:59], v[56:59], v[84:87]
    s_branch L_ST_GO
L_ST_UP:
    s_waitcnt lgkmcnt(3)
    v_mfma_f32_16x16x32_bf16 v[92:95], v[44:47], v[28:31], 0
    v_mfma_f32_16x16x32_bf16 v[84:87], v[44:47], v[124:127], 0
    s_waitcnt lgkmcnt(2)
    v_mfma_f32_16x16x32_bf16 v[92:95], v[48:51], v[32:35], v[92:95]
    v_mfma_f32_16x16x32_bf16 v[84:87], v[48:51], v[124:127], v[84:87]
    s_waitcnt lgkmcnt(1)
    v_mfma_f32_16x16x32_bf16 v[92:95], v[52:55], v[36:39], v[92:95]
    v_mfma_f32_16x16x32_bf16 v[84:87], v[52:55], v[124:127], v[84:87]
    s_waitcnt lgkmcnt(0)
    v_mfma_f32_16x16x32_bf16 v[92:95], v[56:59], v[40:43], v[92:95]
    v_mfma_f32_16x16x32_bf16 v[84:87], v[56:59], v[124:127], v[84:87]
L_ST_GO:
    s_nop 6
    v_mov_b32_dpp v97, v92 row_ror:8 row_mask:0xf bank_mask:0xf
    v_cndmask_b32 v96, v93, v84, s[10:11]
    s_mov_b64 exec, 0x1ff
    s_cmp_eq_u32 s96, 0
    s_cbranch_scc1 S21
    buffer_store_dwordx4 v[96:99], v27, s[16:19], s33 offen
    s_branch S22
S21:
    buffer_store_dwordx4 v[96:99], v27, s[16:19], s33 offen sc1
S22:
    s_mov_b64 exec, -1
    s_mov_b32 s14, 2097152
    buffer_load_dwordx4 v[104:107], v20, s[16:19], s28 offen sc1
    buffer_load_dwordx4 v[108:111], v22, s[16:19], s28 offen offset:2048 sc1
    buffer_load_dwordx4 v[120:123], v20, s[16:19], s28 offen offset:1024 sc1
    s_branch C25
P23:
    s_mov_b64 exec, s[40:41]
    s_cbranch_execz K26
    buffer_load_dwordx4 v[104:107], v20, s[16:19], s28 offen sc1
K26:
    s_mov_b64 exec, s[42:43]
    s_cbranch_execz K27
    buffer_load_dwordx4 v[108:111], v22, s[16:19], s28 offen offset:2048 sc1
K27:
    s_mov_b64 exec, s[44:45]
    s_cbranch_execz K28
    buffer_load_dwordx4 v[120:123], v20, s[16:19], s28 offen offset:1024 sc1
K28:
    s_mov_b64 exec, -1
C25:
    s_waitcnt vmcnt(0)
    v_xor_b32 v84, s6, v106
    v_xor_b32 v88, s7, v107
    v_or_b32 v84, v84, v88
    v_xor_b32 v85, s6, v110
    v_xor_b32 v89, s7, v111
    v_or_b32 v85, v85, v89
    v_xor_b32 v86, s6, v122
    v_xor_b32 v90, s7, v123
    v_or_b32 v86, v86, v90
    v_cmp_ne_u32 s[40:41], 0, v84
    v_cmp_ne_u32 s[42:43], 0, v85
    v_cmp_ne_u32 s[44:45], 0, v86
    s_sub_u32 s14, s14, 1
    s_cbranch_scc1 D24
    s_or_b64 vcc, s[40:41], s[42:43]
    s_or_b64 vcc, vcc, s[44:45]
    s_cbranch_scc1 P23
D24:
    v_add_f32_dpp v108, v108, v108 quad_perm:[2,3,0,1] row_mask:0xf bank_mask:0xf
    v_add_f32_dpp v104, v104, v104 quad_perm:[2,3,0,1] row_mask:0xf bank_mask:0xf
    v_add_f32_dpp v105, v105, v105 quad_perm:[2,3,0,1] row_mask:0xf bank_mask:0xf
    v_add_f32_dpp v120, v120, v120 quad_perm:[2,3,0,1] row_mask:0xf bank_mask:0xf
    v_add_f32_dpp v121, v121, v121 quad_perm:[2,3,0,1] row_mask:0xf bank_mask:0xf
    v_add_f32_dpp v109, v108, v108 row_shr:4 row_mask:0xf bank_mask:0xa
    v_add_f32_dpp v106, v104, v104 row_shr:4 row_mask:0xf bank_mask:0xa
    v_add_f32_dpp v107, v105, v105 row_shr:4 row_mask:0xf bank_mask:0xa
    v_add_f32_dpp v122, v120, v120 row_shr:4 row_mask:0xf bank_mask:0xa
    v_add_f32_dpp v123, v121, v121 row_shr:4 row_mask:0xf bank_mask:0xa
    v_add_f32_dpp v109, v108, v108 row_shl:4 row_mask:0xf bank_mask:0x5
    v_add_f32_dpp v106, v104, v104 row_shl:4 row_mask:0xf bank_mask:0x5
    v_add_f32_dpp v107, v105, v105 row_shl:4 row_mask:0xf bank_mask:0x5
    v_add_f32_dpp v122, v120, v120 row_shl:4 row_mask:0xf bank_mask:0x5
    v_add_f32_dpp v123, v121, v121 row_shl:4 row_mask:0xf bank_mask:0x5
    v_mov_b32_dpp v108, v109 row_ror:8 row_mask:0xf bank_mask:0xf
    v_cndmask_b32 v110, v108, v109, s[8:9]
    v_cndmask_b32 v111, v109, v108, s[8:9]
    v_mul_f32 v110, 0x3b000000, v110
    v_mul_f32 v111, 0x3b000000, v111
    v_fma_f32 v111, -v110, v110, v111
    v_max_f32 v111, 0, v111
    v_cvt_pk_bf16_f32 v15, v110, v111
    v_lshlrev_b32 v13, 16, v15
    v_and_b32 v14, s58, v15
    v_add_f32 v14, 0x3727c5ac, v14
    v_cvt_pk_bf16_f32 v14, v14, v14
    v_and_b32 v14, s58, v14
    v_sqrt_f32 v14, v14
    s_nop 0
    v_cvt_pk_bf16_f32 v14, v14, v14
    v_and_b32 v14, s58, v14
    v_rcp_f32 v14, v14
    v_fma_f32 v104, -v13, v122, v106
    v_fma_f32 v105, -v13, v123, v107
    v_mul_f32 v104, v104, v14
    v_mul_f32 v105, v105, v14
    v_cvt_pk_bf16_f32 v15, v104, v105
    v_lshlrev_b32 v104, 16, v15
    v_and_b32 v105, s58, v15
    v_max_f32 v106, 0, v104
    v_max_f32 v107, 0, v105
    v_cndmask_b32 v104, v106, v104, s[8:9]
    v_cndmask_b32 v105, v107, v105, s[8:9]
    s_nop 0
    v_mul_f32_dpp v104, v104, v104 row_ror:8 row_mask:0xf bank_mask:0xf
    v_mul_f32_dpp v105, v105, v105 row_ror:8 row_mask:0xf bank_mask:0xf
    v_cvt_pk_bf16_f32 v15, v104, v105
    s_nop 1
    v_mov_b32_dpp v134, v15 quad_perm:[0,0,2,2] row_mask:0xf bank_mask:0xf
    v_mov_b32_dpp v135, v15 quad_perm:[1,1,3,3] row_mask:0xf bank_mask:0xf
    s_nop 1
    v_mfma_f32_16x16x16_bf16 v[60:63], v[134:135], v[76:77], 0
    v_mfma_f32_16x16x16_bf16 v[64:67], v[134:135], v[78:79], 0
    v_mfma_f32_16x16x16_bf16 v[68:71], v[134:135], v[80:81], 0
    v_mfma_f32_16x16x16_bf16 v[72:75], v[134:135], v[82:83], 0
    s_nop 5
    v_cndmask_b32 v96, v60, v64, s[98:99]
    s_mov_b32 exec_lo, 0
    v_mov_b32 v96, v68
    s_mov_b32 exec_hi, s58
    v_mov_b32 v96, v72
    s_mov_b64 exec, -1
    s_nop 0
    v_mov_b32_dpp v97, v96 row_ror:8 row_mask:0xf bank_mask:0xf
    s_mov_b32 exec_lo, 0xff00ff
    s_mov_b32 exec_hi, exec_lo
    buffer_store_dwordx4 v[96:99], v24, s[16:19], s25 offen sc1
    s_mov_b64 exec, -1
    s_endpgm
L_RED:
    s_barrier
    s_load_dwordx2 s[20:21], s[0:1], 72
    s_mov_b64 s[22:23], s[38:39]
    v_lshrrev_b32 v12, 3, v0
    v_and_b32 v8, 31, v12
    v_mul_u32_u24 v8, 128, v8
    v_add_u32 v8, v8, v25
    v_mul_u32_u24 v12, 128, v12
    v_add_u32 v12, v12, v25
    s_lshl_b32 s24, s4, 5
    s_add_u32 s24, s29, 0
    s_mul_i32 s24, s24, 4096
    s_add_u32 s24, s24, 0x200000
    v_lshlrev_b32 v9, 1, v5
    s_lshl_b32 s27, s29, 5
    buffer_load_ushort v134, v9, s[36:39], s27 offen
    v_lshl_or_b32 v10, v4, 3, v7
    v_lshl_or_b32 v10, v10, 3, v3
    v_lshlrev_b32 v10, 2, v10
    v_lshlrev_b32 v11, 5, v5
    v_lshl_or_b32 v11, v6, 3, v11
    s_mul_i32 s25, s29, 16384
    s_add_u32 s25, s25, 0x380000
    s_cmp_lt_u32 s3, 6
    s_cselect_b32 s26, 8192, 0
    s_cselect_b32 s59, 1.0, 0
    s_add_u32 s26, s26, s25
    s_mov_b32 s14, 2097152
    buffer_load_dwordx4 v[104:107], v8, s[16:19], s24 offen sc1
    s_branch C31
P29:
    s_mov_b64 exec, s[40:41]
    s_cbranch_execz K32
    buffer_load_dwordx4 v[104:107], v8, s[16:19], s24 offen sc1
K32:
    s_mov_b64 exec, -1
C31:
    s_waitcnt vmcnt(0)
    v_xor_b32 v84, s6, v106
    v_xor_b32 v88, s7, v107
    v_or_b32 v84, v84, v88
    v_cmp_ne_u32 s[40:41], 0, v84
    s_sub_u32 s14, s14, 1
    s_cbranch_scc1 D30
    s_or_b64 vcc, s[40:41], s[40:41]
    s_cbranch_scc1 P29
D30:
    v_permlane32_swap_b32 v104, v105
    v_add_f32 v104, v104, v105
    v_mov_b32 v105, v104
    s_nop 1
    v_permlane16_swap_b32 v104, v105
    v_add_f32 v104, v104, v105
    s_nop 1
    v_add_f32_dpp v104, v104, v104 row_ror:8 row_mask:0xf bank_mask:0xf
    ds_write_b32 v10, v104 offset:4480
    v_lshlrev_b32 v134, 16, v134
    s_waitcnt lgkmcnt(0)
    s_barrier
    ds_read_b64 v[112:113], v11 offset:4480
    s_waitcnt lgkmcnt(0)
    v_add_f32 v112, v112, v113
    v_mov_b32 v113, v112
    s_nop 1
    v_permlane16_swap_b32 v112, v113
    v_add_f32 v112, v112, v113
    v_cvt_pk_bf16_f32 v112, v112, v112
    v_and_b32 v112, s58, v112
    v_add_f32 v112, v112, v134
    v_cvt_pk_bf16_f32 v112, v112, v112
    v_lshlrev_b32 v134, 16, v112
    s_mov_b32 s14, 2097152
    buffer_load_dwordx4 v[104:107], v12, s[16:19], s25 offen sc1
    buffer_load_dwordx4 v[108:111], v12, s[16:19], s26 offen sc1
    s_branch C35
P33:
    s_mov_b64 exec, s[40:41]
    s_cbranch_execz K36
    buffer_load_dwordx4 v[104:107], v12, s[16:19], s25 offen sc1
K36:
    s_mov_b64 exec, s[42:43]
    s_cbranch_execz K37
    buffer_load_dwordx4 v[108:111], v12, s[16:19], s26 offen sc1
K37:
    s_mov_b64 exec, -1
C35:
    s_waitcnt vmcnt(0)
    v_xor_b32 v84, s6, v106
    v_xor_b32 v88, s7, v107
    v_or_b32 v84, v84, v88
    v_xor_b32 v85, s6, v110
    v_xor_b32 v89, s7, v111
    v_or_b32 v85, v85, v89
    v_cmp_ne_u32 s[40:41], 0, v84
    v_cmp_ne_u32 s[42:43], 0, v85
    s_sub_u32 s14, s14, 1
    s_cbranch_scc1 D34
    s_or_b64 vcc, s[40:41], s[42:43]
    s_cbranch_scc1 P33
D34:
    s_cmp_lt_u32 s3, 6
    s_cbranch_scc0 L_R_ONE
    v_pk_add_f32 v[104:105], v[104:105], v[108:109]
L_R_ONE:
    s_nop 1
    v_permlane32_swap_b32 v104, v105
    v_add_f32 v104, v104, v105
    v_mov_b32 v105, v104
    s_nop 1
    v_permlane16_swap_b32 v104, v105
    v_add_f32 v104, v104, v105
    s_nop 1
    v_add_f32_dpp v104, v104, v104 row_ror:8 row_mask:0xf bank_mask:0xf
    ds_write_b32 v10, v104 offset:4992
    s_waitcnt lgkmcnt(0)
    s_barrier
    s_cmp_lg_u32 s3, 0
    s_cbranch_scc1 L_FIN
    ds_read_b64 v[104:105], v11 offset:4992
    s_waitcnt lgkmcnt(0)
    v_add_f32 v104, v104, v105
    v_mov_b32 v105, v104
    s_nop 1
    v_permlane16_swap_b32 v104, v105
    v_add_f32 v104, v104, v105
    v_mov_b32 v105, v104
    s_nop 1
    v_permlane32_swap_b32 v104, v105
    v_add_f32 v104, v104, v105
    v_cvt_pk_bf16_f32 v104, v104, v104
    v_and_b32 v104, s58, v104
    v_add_f32 v104, v104, v134
    v_cvt_pk_bf16_f32 v104, v104, v104
    s_mov_b64 exec, 0xffff
    buffer_store_short v104, v9, s[20:23], s27 offen
    s_cmp_lg_u32 s29, 0
    s_cbranch_scc1 L_NOEP
    s_mov_b64 exec, 1
    buffer_store_dword v98, v9, s[16:19], 0 offen offset:0
L_NOEP:
    s_mov_b64 exec, -1
L_FIN:
    s_endpgm
L_E1_RETRY:
    s_mov_b32 s26, 0x24000
    s_mov_b32 s14, 2097152
    buffer_load_dwordx4 v[104:107], v8, s[16:19], s24 offen sc1
    buffer_load_dwordx4 v[108:111], v8, s[16:19], s25 offen sc1
    s_branch C40
P38:
    s_add_u32 s24, s24, s26
    s_add_u32 s25, s25, s26
    s_sub_u32 s26, 0, s26
    s_mov_b64 exec, s[40:41]
    s_cbranch_execz K41
    buffer_load_dwordx4 v[104:107], v8, s[16:19], s24 offen sc1
K41:
    s_mov_b64 exec, s[42:43]
    s_cbranch_execz K42
    buffer_load_dwordx4 v[108:111], v8, s[16:19], s25 offen sc1
K42:
    s_mov_b64 exec, -1
C40:
    s_waitcnt vmcnt(0)
    v_xor_b32 v84, s6, v106
    v_xor_b32 v88, s7, v107
    v_or_b32 v84, v84, v88
    v_xor_b32 v85, s6, v110
    v_xor_b32 v89, s7, v111
    v_or_b32 v85, v85, v89
    v_cmp_ne_u32 s[40:41], 0, v84
    v_cmp_ne_u32 s[42:43], 0, v85
    s_sub_u32 s14, s14, 1
    s_cbranch_scc1 D39
    s_or_b64 vcc, s[40:41], s[42:43]
    s_cbranch_scc1 P38
D39:
    s_branch L_E1_OK
.p2align 12, 0
.section .rodata,"a"
.p2align 6
.amdhsa_kernel sequential_preLN__sliding_block_cached__glu_gated_reglu__decode_kernel
  .amdhsa_next_free_vgpr 144
  .amdhsa_next_free_sgpr 102
  .amdhsa_accum_offset 144
  .amdhsa_group_segment_fixed_size 0
  .amdhsa_kernarg_size 96
  .amdhsa_user_sgpr_count 2
  .amdhsa_user_sgpr_kernarg_segment_ptr 1
  .amdhsa_system_sgpr_workgroup_id_x 1
  .amdhsa_float_denorm_mode_32 3
.end_amdhsa_kernel
```
